```python
import torch

def _softmax(x, axis=-1):
    return torch.softmax(x, dim=axis)
def _gelu(x):
    return torch.nn.functional.gelu(x, approximate="tanh")
def _silu(x):
    return torch.nn.functional.silu(x)
def _sigmoid(x):
    return torch.sigmoid(x)
def _layernorm(x, axis=-1, eps=1e-5):
    m = x.mean(dim=axis, keepdim=True)
    v = x.var(dim=axis, keepdim=True, unbiased=False)
    return (x - m) / torch.sqrt(v + eps)
def _scatter_add(tgt, idx, src, axis=0):
    return tgt.clone().index_add_(axis, idx, src)
def _segment_sum(src, seg, n):
    out = torch.zeros((n,) + src.shape[1:], dtype=src.dtype)
    return out.index_add_(0, seg, src)
def _pad(x, pw):
    flat = tuple(v for pair in reversed(pw) for v in pair)
    return torch.nn.functional.pad(x, flat)

kernel_name = 'parallel_sum__sliding_block_cached__geglu_ffn__decode'

def setup_inputs():

    _w = (lambda a: (lambda t: t.to(torch.bfloat16) if t.is_floating_point() else t)(torch.as_tensor(a)))
    def _A_setup():
        B, Sq, D = 1, 1, 512
        Hq, Hkv, Sk, Dh = 32, 8, 65536, 128
        assert Hq % Hkv == 0, (Hq, Hkv)
        return {
            "x": _w((lambda *s: torch.randn(*s, dtype=torch.bfloat16) * 0.05)(B, Sq, D)),
            "k_cache": _w((lambda *s: torch.randn(*s, dtype=torch.bfloat16) * 3.2)(B, Hkv, Sk, Dh)),
            "v_cache": _w((lambda *s: torch.randn(*s, dtype=torch.bfloat16) * 1.6)(B, Hkv, Sk, Dh)),
            "wq": _w((lambda *s: torch.randn(*s, dtype=torch.bfloat16) * 3.2)(D, Hq * Dh) * (D ** -0.5)),
            "wo": _w((lambda *s: torch.randn(*s, dtype=torch.bfloat16) * 1.6)(Hq * Dh, D) * ((Hq * Dh) ** -0.5)),
        }
    _A_in = _A_setup()

    def _B_setup():
        B, S, D, F = 1, 1, 512, 1792
        return {
            "x": _w((lambda *s: torch.randn(*s, dtype=torch.bfloat16) * 0.05)(B, S, D)),
            "w_gate": _w((lambda *s: torch.randn(*s, dtype=torch.bfloat16) * 0.05)(D, F)),
            "w_up": _w((lambda *s: torch.randn(*s, dtype=torch.bfloat16) * 0.05)(D, F)),
            "w_down": _w((lambda *s: torch.randn(*s, dtype=torch.bfloat16) * 0.05)(F, D)),
        }
    _B_in = _B_setup()

    return {
        "A_x": _A_in["x"],
        "A_k_cache": _A_in["k_cache"],
        "A_v_cache": _A_in["v_cache"],
        "A_wq": _A_in["wq"],
        "A_wo": _A_in["wo"],
        "B_x": _B_in["x"],
        "B_w_gate": _B_in["w_gate"],
        "B_w_up": _B_in["w_up"],
        "B_w_down": _B_in["w_down"],
    }

def reference(A_x, A_k_cache, A_v_cache, A_wq, A_wo, B_x, B_w_gate, B_w_up, B_w_down):
    def _A_ref(x, k_cache, v_cache, wq, wo):
        B, Sq, D = x.shape
        Hq, Dh = 32, 128
        Hkv, Sk = k_cache.shape[1], k_cache.shape[2]
        W = min(4096, max(256, Sk // 4))
        rep = Hq // Hkv
        q = (lambda x, *d: x.permute(*d))((x @ wq).reshape(B, Sq, Hq, Dh), 0, 2, 1, 3)
        k = (lambda x, n, axis: torch.repeat_interleave(x, n, dim=axis))(k_cache[:, :, Sk - W:, :], rep, axis=1)
        v = (lambda x, n, axis: torch.repeat_interleave(x, n, dim=axis))(v_cache[:, :, Sk - W:, :], rep, axis=1)
        scores = torch.einsum("bhqd,bhkd->bhqk", q, k) * (Dh ** -0.5)
        p = _softmax(scores, axis=-1)
        o = torch.einsum("bhqk,bhkd->bhqd", p, v)
        return (lambda x, *d: x.permute(*d))(o, 0, 2, 1, 3).reshape(B, Sq, Hq * Dh) @ wo

    def _B_ref(x, w_gate, w_up, w_down):
        return (_gelu(x @ w_gate) * (x @ w_up)) @ w_down

    x = A_x
    xn = _layernorm(x, axis=-1)
    return x + _A_ref(xn, A_k_cache, A_v_cache, A_wq, A_wo) + _B_ref(xn, B_w_gate, B_w_up, B_w_down)
```

```asm
; @launch grid=(256,1,1) block=(512,1,1) lds=75776
.amdgcn_target "amdgcn-amd-amdhsa--gfx950"
.text
.globl parallel_sum__sliding_block_cached__geglu_ffn__decode_kernel
.p2align 8
.type parallel_sum__sliding_block_cached__geglu_ffn__decode_kernel,@function
parallel_sum__sliding_block_cached__geglu_ffn__decode_kernel:
  s_cmpk_ge_u32 s2, 256
  s_cbranch_scc1 L_end
  s_load_dwordx16 s[4:19], s[0:1], 0
  s_load_dwordx8 s[20:27], s[0:1], 64
  v_readfirstlane_b32 s3, v0
  v_and_b32 v1, 63, v0
  s_and_b32 s28, s2, 7
  s_lshr_b32 s29, s2, 3
  v_lshlrev_b32 v4, 4, v1
  s_lshr_b32 s3, s3, 6
  s_cmp_lt_u32 s3, 4
  s_cbranch_scc0 L_attn
  s_lshr_b32 s36, s2, 6
  s_and_b32 s37, s29, 7
  v_lshrrev_b32 v22, 3, v0
  v_and_b32 v23, 0x70, v4
  s_lshl3_add_u32 s38, s28, s37
  s_lshl_b32 s38, s38, 7
  s_lshl_b32 s39, s36, 20
  s_add_u32 s38, s38, s39
  v_lshl_add_u32 v96, v22, 15, v23
  v_add_u32 v96, s38, v96
  s_lshl_b32 s38, s36, 8
  v_lshl_add_u32 v5, v22, 3, s38
  s_movk_i32 s45, 0x2000
  s_mul_i32 s42, s28, 7
  s_min_u32 s41, s37, 6
  s_add_u32 s41, s41, s42
  s_lshr_b32 s43, s41, 1
  s_mul_i32 s44, s36, 3584
  s_add_u32 s44, s44, s43
  s_lshl_b32 s44, s44, 7
  v_mul_u32_u24 v100, 14336, v22
  v_add3_u32 v100, v100, v23, s44
  s_bitcmp0_b32 s41, 0
  s_waitcnt lgkmcnt(0)
  global_load_dwordx4 v[16:19], v4, s[4:5]
  global_load_dwordx2 v[36:37], v5, s[4:5]
  s_load_dword s30, s[26:27], 0
  global_load_dwordx4 v[40:43], v96, s[10:11] nt
  v_add_u32 v96, s45, v96
  global_load_dwordx4 v[44:47], v96, s[10:11] nt
  v_add_u32 v96, s45, v96
  global_load_dwordx4 v[48:51], v96, s[10:11] nt
  v_add_u32 v96, s45, v96
  global_load_dwordx4 v[52:55], v96, s[10:11] nt
  s_cselect_b32 s16, s16, s18
  s_cselect_b32 s17, s17, s19
  s_barrier
  global_load_dwordx4 v[56:59], v100, s[16:17] offset:0 nt
  global_load_dwordx4 v[60:63], v100, s[16:17] offset:3584 nt
  v_add_u32 v100, 7168, v100
  global_load_dwordx4 v[64:67], v100, s[16:17] offset:0 nt
  global_load_dwordx4 v[68:71], v100, s[16:17] offset:3584 nt
  s_branch L_gemv2
L_attn:
  s_getpc_b64 s[58:59]
L_pc:
  v_lshlrev_b32 v5, 5, v0
  v_min_u32 v5, L_code_end-L_pc-4+8192, v5
  v_subrev_u32 v5, 4096, v5
  global_load_dword v12, v5, s[58:59] offset:-4096
  s_and_b32 s61, s3, 3
  v_and_b32 v22, 48, v0
  s_lshl_b32 s39, s28, 17
  v_add_u32 v6, s39, v4
  s_mul_i32 s53, s61, 8704
  s_lshl2_add_u32 s52, s29, s61
  s_lshl_b32 s52, s52, 10
  s_lshl_b32 s39, s28, 24
  s_add_u32 s52, s52, s39
  s_add_u32 s52, s52, 15728640
  v_xor_b32 v5, v6, v22
  s_mov_b32 s54, 0x20000
  s_mov_b32 s55, 0xfffff
  s_waitcnt lgkmcnt(0)
  s_add_u32 s6, s6, s52
  s_addc_u32 s7, s7, 0
  s_barrier
  s_add_u32 s8, s8, s52
  s_addc_u32 s9, s9, 0
  v_lshlrev_b32 v22, 2, v22
  v_xor_b32 v6, v6, v22
  s_add_u32 m0, s53, 6144
  s_nop 0
  global_load_lds_dwordx4 v5, s[6:7] nt
  s_add_u32 m0, s53, 7232
  v_add_u32 v5, s54, v5
  v_and_b32 v5, s55, v5
  global_load_lds_dwordx4 v5, s[6:7] nt
  s_branch L_attn2
L_gemv2:
  v_lshrrev_b32 v15, 6, v0
  v_and_b32 v2, 15, v0
  v_and_b32 v22, 1, v0
  v_lshlrev_b32 v22, 4, v22
  v_mov_b32 v25, 0xffff
  v_lshlrev_b32 v22, v22, v25
  v_bfe_u32 v25, v0, 1, 2
  v_cmp_eq_u32 vcc, 0, v25
  v_mov_b32 v12, 0
  v_lshlrev_b32 v20, 2, v15
  v_cndmask_b32 v8, 0, v22, vcc
  v_cmp_eq_u32 vcc, 1, v25
  v_lshrrev_b32 v24, 5, v1
  v_lshlrev_b32 v23, 5, v2
  v_cndmask_b32 v9, 0, v22, vcc
  v_cmp_eq_u32 vcc, 2, v25
  v_lshl_add_u32 v23, v15, 9, v23
  v_and_b32 v26, 16, v0
  v_cndmask_b32 v10, 0, v22, vcc
  v_cmp_eq_u32 vcc, 3, v25
  v_add_u32 v23, v23, v26
  v_lshl_add_u32 v6, v24, 3, v23
  v_cndmask_b32 v11, 0, v22, vcc
  ds_write_b32 v20, v12 offset:1184
  s_lshl2_add_u32 s49, s28, s36
  s_lshl3_add_u32 s49, s49, s37
  s_lshl_b32 s49, s49, 8
  s_add_u32 s49, s49, 4096
  v_add_u32 v7, s49, v4
  v_mov_b32 v21, 0x3b000000
  s_getreg_b32 s31, hwreg(HW_REG_XCC_ID, 0, 4)
  v_and_b32 v22, 3, v0
  v_lshlrev_b32 v102, 3, v22
  v_cmp_eq_u32 vcc, 3, v22
  s_lshl_b32 s31, s31, 24
  s_lshl4_add_u32 s38, s28, s3
  s_lshl_b32 s38, s38, 9
  s_add_u32 s38, s38, 8192
  v_cndmask_b32 v103, 0, 3, vcc
  v_and_b32 v27, 31, v0
  v_lshl_add_u32 v22, v27, 4, s38
  v_lshl_add_u32 v112, v24, 11, v22
  s_waitcnt vmcnt(8)
  v_readfirstlane_b32 s38, v16
  v_lshlrev_b32 v22, 16, v16
  v_and_b32 v23, 0xffff0000, v16
  v_lshlrev_b32 v24, 16, v17
  v_and_b32 v25, 0xffff0000, v17
  v_lshlrev_b32 v26, 16, v18
  v_and_b32 v27, 0xffff0000, v18
  v_lshlrev_b32 v28, 16, v19
  v_and_b32 v29, 0xffff0000, v19
  s_and_b32 s38, s38, 0xffff0000
  v_subrev_f32 v22, s38, v22
  v_subrev_f32 v23, s38, v23
  v_subrev_f32 v24, s38, v24
  v_subrev_f32 v25, s38, v25
  v_subrev_f32 v26, s38, v26
  v_subrev_f32 v27, s38, v27
  v_subrev_f32 v28, s38, v28
  v_subrev_f32 v29, s38, v29
  v_pk_add_f32 v[30:31], v[22:23], v[24:25]
  v_pk_mul_f32 v[34:35], v[22:23], v[22:23]
  v_pk_add_f32 v[32:33], v[26:27], v[28:29]
  v_pk_fma_f32 v[34:35], v[24:25], v[24:25], v[34:35]
  v_pk_add_f32 v[30:31], v[30:31], v[32:33]
  v_pk_fma_f32 v[34:35], v[26:27], v[26:27], v[34:35]
  v_add_f32 v30, v30, v31
  v_pk_fma_f32 v[34:35], v[28:29], v[28:29], v[34:35]
  v_add_f32 v34, v34, v35
  v_lshlrev_b32 v22, 16, v36
  v_add_f32_dpp v30, v30, v30 row_ror:8 row_mask:0xf bank_mask:0xf
  v_add_f32_dpp v34, v34, v34 row_ror:8 row_mask:0xf bank_mask:0xf
  v_and_b32 v23, 0xffff0000, v36
  v_add_f32_dpp v30, v30, v30 row_ror:4 row_mask:0xf bank_mask:0xf
  v_add_f32_dpp v34, v34, v34 row_ror:4 row_mask:0xf bank_mask:0xf
  v_lshlrev_b32 v24, 16, v37
  v_add_f32_dpp v30, v30, v30 row_ror:2 row_mask:0xf bank_mask:0xf
  v_add_f32_dpp v34, v34, v34 row_ror:2 row_mask:0xf bank_mask:0xf
  v_and_b32 v25, 0xffff0000, v37
  v_add_f32_dpp v30, v30, v30 row_ror:1 row_mask:0xf bank_mask:0xf
  v_add_f32_dpp v34, v34, v34 row_ror:1 row_mask:0xf bank_mask:0xf
  s_nop 0
  v_add_f32_dpp v30, v30, v30 row_bcast:15 row_mask:0xa bank_mask:0xf
  v_add_f32_dpp v34, v34, v34 row_bcast:15 row_mask:0xa bank_mask:0xf
  s_nop 0
  v_add_f32_dpp v30, v30, v30 row_bcast:31 row_mask:0xc bank_mask:0xf
  v_add_f32_dpp v34, v34, v34 row_bcast:31 row_mask:0xc bank_mask:0xf
  v_readlane_b32 s39, v30, 63
  v_readlane_b32 s51, v34, 63
  s_nop 0
  v_mul_f32 v30, s39, v21
  v_mul_f32 v32, s51, v21
  v_fma_f32 v32, -v30, v30, v32
  v_add_f32 v30, s38, v30
  v_max_f32 v32, 0, v32
  v_cvt_pk_bf16_f32 v30, 0, v30
  v_cvt_pk_bf16_f32 v32, 0, v32
  v_pk_add_f32 v[22:23], v[22:23], v[30:31] op_sel_hi:[1,0] neg_lo:[0,1] neg_hi:[0,1]
  v_add_f32 v32, 0x3727c5ac, v32
  v_pk_add_f32 v[24:25], v[24:25], v[30:31] op_sel_hi:[1,0] neg_lo:[0,1] neg_hi:[0,1]
  v_cvt_pk_bf16_f32 v32, 0, v32
  v_cvt_pk_bf16_f32 v22, 0, v22
  v_sqrt_f32 v32, v32
  v_cvt_pk_bf16_f32 v23, 0, v23
  v_cvt_pk_bf16_f32 v32, 0, v32
  v_cvt_pk_bf16_f32 v24, 0, v24
  v_rcp_f32 v32, v32
  v_cvt_pk_bf16_f32 v25, 0, v25
  v_pk_mul_f32 v[22:23], v[22:23], v[32:33] op_sel_hi:[1,0]
  v_pk_mul_f32 v[24:25], v[24:25], v[32:33] op_sel_hi:[1,0]
  v_cvt_pk_bf16_f32 v22, v22, v22
  v_cvt_pk_bf16_f32 v23, v23, v23
  v_cvt_pk_bf16_f32 v24, v24, v24
  v_cvt_pk_bf16_f32 v25, v25, v25
  v_and_b32 v72, v22, v8
  v_and_b32 v73, v22, v9
  v_and_b32 v74, v22, v10
  v_and_b32 v75, v22, v11
  v_and_b32 v76, v23, v8
  v_and_b32 v77, v23, v9
  v_and_b32 v78, v23, v10
  v_and_b32 v79, v23, v11
  v_and_b32 v80, v24, v8
  v_and_b32 v81, v24, v9
  v_and_b32 v82, v24, v10
  v_and_b32 v83, v24, v11
  v_and_b32 v84, v25, v8
  v_and_b32 v85, v25, v9
  v_and_b32 v86, v25, v10
  v_and_b32 v87, v25, v11
  s_waitcnt vmcnt(7)
  v_mfma_f32_16x16x32_bf16 v[104:107], v[72:75], v[40:43], 0
  s_waitcnt vmcnt(6)
  v_mfma_f32_16x16x32_bf16 v[104:107], v[76:79], v[44:47], v[104:107]
  s_waitcnt vmcnt(5)
  v_mfma_f32_16x16x32_bf16 v[104:107], v[80:83], v[48:51], v[104:107]
  s_waitcnt vmcnt(4)
  v_mfma_f32_16x16x32_bf16 v[104:107], v[84:87], v[52:55], v[104:107]
  s_waitcnt lgkmcnt(0)
  s_add_u32 s30, s30, 0x9E3779B1
  s_or_b32 s30, s30, 1
  s_and_b32 s38, s30, 0xf0ffffff
  s_or_b32 s31, s31, s38
  v_lshrrev_b32 v99, v102, s31
  v_and_b32 v96, 3, v99
  v_bfe_u32 v97, v99, 2, 2
  v_bfe_u32 v98, v99, 4, 2
  v_bfe_u32 v99, v99, 6, 2
  v_permlane32_swap_b32 v104, v106
  v_permlane32_swap_b32 v105, v107
  s_nop 0
  v_add_f32_dpp v22, v106, v104 row_ror:8 row_mask:0xf bank_mask:0xf
  v_add_f32_dpp v23, v107, v105 row_ror:8 row_mask:0xf bank_mask:0xf
  ds_write_b64 v6, v[22:23] offset:1536
  s_cmp_lg_u32 s3, 0
  s_waitcnt lgkmcnt(0)
  s_barrier
  s_cbranch_scc1 L_t0done
  ds_read_b128 v[24:27], v4 offset:1536
  ds_read_b128 v[28:31], v4 offset:2048
  ds_read_b128 v[32:35], v4 offset:2560
  ds_read_b128 v[36:39], v4 offset:3072
  s_waitcnt lgkmcnt(2)
  v_pk_add_f32 v[24:25], v[24:25], v[28:29]
  v_pk_add_f32 v[26:27], v[26:27], v[30:31]
  s_waitcnt lgkmcnt(0)
  s_mov_b64 exec, 0xffff
  v_pk_add_f32 v[32:33], v[32:33], v[36:37]
  v_pk_add_f32 v[34:35], v[34:35], v[38:39]
  v_pk_add_f32 v[24:25], v[24:25], v[32:33]
  v_pk_add_f32 v[26:27], v[26:27], v[34:35]
  v_and_or_b32 v16, v24, -4, v96
  v_and_or_b32 v17, v25, -4, v97
  v_and_or_b32 v18, v26, -4, v98
  v_and_or_b32 v19, v27, -4, v99
  global_store_dwordx4 v7, v[16:19], s[26:27]
  ds_write_b128 v4, v[16:19] offset:1280
  s_branch L_t0end
L_t0done:
  s_mov_b64 exec, 1
  global_load_dword v125, v4, s[4:5]
L_t0end:
  s_mov_b64 exec, -1
  s_barrier
  global_load_dwordx4 v[40:43], v112, s[26:27] offset:-4096 sc1
  global_load_dwordx4 v[44:47], v112, s[26:27] sc1
  s_and_b32 s32, s30, 0xff
  s_bfe_u32 s33, s30, 0x80008
  s_bfe_u32 s34, s30, 0x80010
  s_lshr_b32 s35, s30, 24
  v_mov_b32 v14, 0xffffff00
  s_mov_b32 s40, 0x100000
  v_bfe_u32 v3, v0, 4, 2
  v_lshrrev_b32 v24, 5, v1
  v_and_b32 v27, 31, v0
  s_and_b32 s38, s41, 1
  s_lshl2_add_u32 s38, s38, s36
  s_mul_i32 s38, s38, 28
  s_add_u32 s38, s38, s43
  s_lshl_b32 s38, s38, 8
  s_add_u32 s38, s38, 139264
  v_add_u32 v101, s38, v4
  s_lshl3_add_u32 s38, s36, s28
  s_lshr_b32 s39, s38, 2
  s_lshl_b32 s39, s39, 11
  s_and_b32 s51, s38, 3
  s_lshl3_add_u32 s51, s51, s37
  s_add_u32 s39, s39, s51
  s_lshl_b32 s39, s39, 4
  s_add_u32 s39, s39, 917504
  v_lshl_add_u32 v120, v1, 9, s39
  s_lshl3_add_u32 s38, s38, s37
  s_lshl_b32 s38, s38, 3
  s_and_b32 s38, s38, 1023
  v_lshl_add_u32 v121, v24, 2, s38
  s_lshr_b32 s46, s29, 2
  s_and_b32 s47, s29, 3
  s_lshl3_add_u32 s38, s47, s28
  s_lshl3_add_u32 s38, s38, s46
  s_lshl_b32 s38, s38, 9
  s_add_u32 s38, s38, 917504
  v_lshl_add_u32 v119, v27, 4, s38
  v_mov_b32 v28, 0
  v_mov_b32 v29, 0
  v_mov_b32 v30, 0
  v_mov_b32 v31, 0
  s_lshl_b32 s38, s3, 3
  s_lshl_b32 exec_lo, 0xff, s38
  s_mov_b32 exec_hi, 0
  global_store_dwordx4 v119, v[28:31], s[26:27] sc1
  s_mov_b64 exec, -1
  s_lshl_b32 s38, s28, 5
  s_add_u32 s38, s38, s29
  s_lshl2_add_u32 s38, s38, s3
  s_lshl_b32 s38, s38, 9
  s_add_u32 s38, s38, 262144
  v_lshl_add_u32 v116, v27, 4, s38
  v_lshlrev_b32 v23, 3, v27
  v_lshl_add_u32 v23, v15, 8, v23
  v_lshl_add_u32 v114, v24, 2, v23
  s_lshl3_add_u32 s38, s28, s46
  s_lshl_b32 s38, s38, 16
  s_lshl_b32 s39, s47, 8
  s_add_u32 s39, s39, 4096
  s_add_u32 s38, s38, s39
  v_lshlrev_b32 v22, 4, v2
  v_lshl_add_u32 v23, v3, 10, v22
  v_lshl_add_u32 v22, v15, 14, v23
  v_add_u32 v126, s38, v22
  v_add_u32 v127, 8192, v126
  s_min_u32 s48, s46, 6
  s_add_u32 s48, s48, s42
  s_lshl_b32 s38, s48, 15
  s_add_u32 s38, s38, s39
  v_lshl_add_u32 v22, v15, 13, v23
  v_add_u32 v124, s38, v22
  s_lshl_b32 s38, s48, 7
  s_add_u32 s38, s38, 139264
  v_lshrrev_b32 v22, 3, v1
  v_mul_u32_u24 v22, 7168, v22
  v_lshl_add_u32 v22, v15, 5, v22
  v_and_b32 v25, 1, v0
  v_lshl_add_u32 v22, v25, 4, v22
  v_add_u32 v123, s38, v22
  v_lshrrev_b32 v23, 1, v27
  v_lshlrev_b32 v23, 4, v23
  v_lshl_add_u32 v122, v25, 8, v23
  s_lshl_b32 s38, s28, 8
  s_add_u32 s38, s38, s46
  s_lshl2_add_u32 s38, s38, s3
  s_lshl_b32 s38, s38, 6
  s_add_u32 s38, s38, 262144
  v_lshrrev_b32 v25, 2, v1
  v_and_b32 v23, 3, v0
  v_lshl_add_u32 v22, v23, 4, s38
  v_lshl_add_u32 v117, v25, 11, v22
  v_add_u32 v118, 0x8000, v117
  s_mul_i32 s38, s3, 544
  v_lshl_add_u32 v115, v27, 4, s38
  v_lshl_add_u32 v113, v15, 10, v4
  s_waitcnt vmcnt(7)
  v_mfma_f32_16x16x32_bf16 v[88:91], v[72:75], v[56:59], 0
  s_waitcnt vmcnt(6)
  v_mfma_f32_16x16x32_bf16 v[88:91], v[76:79], v[60:63], v[88:91]
  s_waitcnt vmcnt(5)
  v_mfma_f32_16x16x32_bf16 v[88:91], v[80:83], v[64:67], v[88:91]
  s_waitcnt vmcnt(4)
  v_mfma_f32_16x16x32_bf16 v[88:91], v[84:87], v[68:71], v[88:91]
  s_nop 7
  v_permlane32_swap_b32 v88, v90
  v_permlane32_swap_b32 v89, v91
  s_nop 0
  v_add_f32_dpp v22, v90, v88 row_ror:8 row_mask:0xf bank_mask:0xf
  v_add_f32_dpp v23, v91, v89 row_ror:8 row_mask:0xf bank_mask:0xf
  ds_write_b64 v6, v[22:23] offset:3584
  ds_write_b32 v20, v14 offset:1184
  s_cmp_lg_u32 s3, 1
  s_cbranch_scc1 L_t1done
  s_cmp_eq_u32 s37, 7
  s_cbranch_scc1 L_t1done
L_t1spin:
  ds_read_b128 v[92:95], v12 offset:1184
  ds_read_b128 v[24:27], v4 offset:3584
  ds_read_b128 v[28:31], v4 offset:4096
  ds_read_b128 v[32:35], v4 offset:4608
  ds_read_b128 v[36:39], v4 offset:5120
  s_waitcnt lgkmcnt(4)
  v_and_b32 v92, v92, v93
  v_and_b32 v94, v94, v95
  v_and_b32 v92, v92, v94
  v_cmp_eq_u32 vcc, 0, v92
  s_waitcnt lgkmcnt(2)
  v_pk_add_f32 v[24:25], v[24:25], v[28:29]
  v_pk_add_f32 v[26:27], v[26:27], v[30:31]
  s_waitcnt lgkmcnt(0)
  s_cbranch_vccnz L_t1spin
  s_mov_b64 exec, 0xffff
  v_pk_add_f32 v[32:33], v[32:33], v[36:37]
  v_pk_add_f32 v[34:35], v[34:35], v[38:39]
  v_pk_add_f32 v[24:25], v[24:25], v[32:33]
  v_pk_add_f32 v[26:27], v[26:27], v[34:35]
  v_and_or_b32 v24, v24, v14, s32
  v_and_or_b32 v25, v25, v14, s33
  v_and_or_b32 v26, v26, v14, s34
  v_and_or_b32 v27, v27, v14, s35
  global_store_dwordx4 v101, v[24:27], s[26:27] sc1
  s_branch L_t1end
L_t1done:
  global_load_dword v125, v121, s[4:5]
L_t1end:
  s_mov_b64 exec, -1
  s_mov_b32 s55, 3
  s_waitcnt vmcnt(2)
L_qspin:
  v_xor_b32 v21, v96, v40
  v_xor_b32 v22, v98, v42
  v_bitop3_b32 v21, v21, v41, v97 bitop3:0xf6
  v_bitop3_b32 v21, v21, v44, v96 bitop3:0xf6
  v_bitop3_b32 v21, v21, v45, v97 bitop3:0xf6
  v_bitop3_b32 v22, v22, v43, v99 bitop3:0xf6
  v_bitop3_b32 v22, v22, v46, v98 bitop3:0xf6
  v_bitop3_b32 v22, v22, v47, v99 bitop3:0xf6
  v_bitop3_b32 v22, v22, v21, v103 bitop3:0xf4
  v_and_b32 v22, 3, v22
  v_and_b32 v40, -4, v40
  v_and_b32 v41, -4, v41
  v_or_b32_dpp v22, v22, v22 quad_perm:[1,0,3,2] row_mask:0xf bank_mask:0xf
  v_and_b32 v42, -4, v42
  v_and_b32 v43, -4, v43
  v_or_b32_dpp v22, v22, v22 quad_perm:[2,3,0,1] row_mask:0xf bank_mask:0xf
  v_cmp_ne_u32 vcc, 0, v22
  v_and_b32 v44, -4, v44
  v_and_b32 v45, -4, v45
  v_and_b32 v46, -4, v46
  v_and_b32 v47, -4, v47
  s_cbranch_vccz L_qok
  s_sub_u32 s55, s55, 1
  s_cbranch_scc0 L_qnohook
  s_mov_b64 exec, 0xffff
L_qhookwait:
  ds_read_b32 v32, v12 offset:1184
  ds_read_b128 v[28:31], v4 offset:1280
  s_waitcnt lgkmcnt(0)
  v_readfirstlane_b32 s38, v32
  s_cmp_eq_u32 s38, 0
  s_cbranch_scc1 L_qhookwait
  global_store_dwordx4 v7, v[28:31], s[26:27] sc1
L_qnohook:
  s_mov_b64 exec, vcc
  global_load_dwordx4 v[40:43], v112, s[26:27] offset:-4096 sc1
  global_load_dwordx4 v[44:47], v112, s[26:27] sc1
  s_sub_u32 s40, s40, 1
  s_cbranch_scc1 L_end
  s_waitcnt vmcnt(0)
  s_branch L_qspin
L_qok:
  s_mov_b64 exec, -1
  v_pk_add_f32 v[28:29], v[40:41], v[44:45]
  v_pk_add_f32 v[30:31], v[42:43], v[46:47]
  v_and_b32 v21, v103, v21
  v_cmp_ne_u32 vcc, 0, v21
  v_permlane32_swap_b32 v28, v30
  v_permlane32_swap_b32 v29, v31
  s_or_b32 s38, vcc_lo, vcc_hi
  v_pk_add_f32 v[28:29], v[28:29], v[30:31]
  v_mov_b32 v21, s38
  v_cvt_pk_bf16_f32 v28, v28, v29
  ds_write_b32 v114, v28 offset:0
  ds_write_b32 v20, v21 offset:1152
  s_waitcnt lgkmcnt(0)
  s_barrier
  global_load_dwordx4 v[108:111], v123, s[26:27] sc1
  global_load_dwordx4 v[72:75], v124, s[20:21] offset:-4096 nt
  global_load_dwordx4 v[76:79], v124, s[20:21] nt
  global_load_dwordx4 v[80:83], v126, s[12:13] offset:-4096 nt
  global_load_dwordx4 v[84:87], v126, s[12:13] offset:0 nt
  global_load_dwordx4 v[88:91], v127, s[12:13] offset:-4096 nt
  global_load_dwordx4 v[92:95], v127, s[12:13] offset:0 nt
  v_lshlrev_b32 v25, 5, v15
  ds_read_b128 v[28:31], v12 offset:1152
  s_waitcnt lgkmcnt(0)
  v_or3_b32 v28, v28, v29, v30
  v_or_b32 v28, v28, v31
  s_nop 0
  v_readfirstlane_b32 s56, v28
  s_cmp_eq_u32 s56, 0
  s_cbranch_scc1 L_alllocal
  s_cmp_lg_u32 s3, 0
  s_cbranch_scc1 L_alllocal
  s_mov_b64 exec, 0xffff
  global_store_dwordx4 v7, v[16:19], s[26:27] sc1
  s_mov_b64 exec, -1
L_alllocal:
  s_barrier
  ds_read_b128 v[28:31], v25 offset:1024
  ds_read_b128 v[32:35], v25 offset:1040
  s_waitcnt lgkmcnt(0)
  v_max3_f32 v18, v28, v30, v32
  v_max_f32 v18, v18, v34
  v_sub_f32 v28, v28, v18
  v_sub_f32 v30, v30, v18
  v_sub_f32 v32, v32, v18
  v_sub_f32 v34, v34, v18
  v_exp_f32 v28, v28
  v_exp_f32 v30, v30
  v_exp_f32 v32, v32
  v_exp_f32 v34, v34
  v_mul_f32 v16, v28, v29
  v_fmac_f32 v16, v30, v31
  v_fmac_f32 v16, v32, v33
  v_fmac_f32 v16, v34, v35
  v_log_f32 v17, v16
  v_rcp_f32 v16, v16
  v_mov_b32 v19, s30
  v_add_f32 v18, v18, v17
  v_mul_f32 v96, v28, v16
  v_mul_f32 v98, v30, v16
  v_mul_f32 v100, v32, v16
  v_mul_f32 v102, v34, v16
  s_cmp_eq_u32 s56, 0
  s_mov_b32 exec_hi, 0
  s_barrier
  ds_read_b128 v[24:27], v115 offset:6144
  ds_read_b128 v[28:31], v115 offset:14848
  ds_read_b128 v[32:35], v115 offset:23552
  ds_read_b128 v[36:39], v115 offset:32256
  s_waitcnt lgkmcnt(3)
  v_pk_mul_f32 v[24:25], v[24:25], v[96:97] op_sel_hi:[1,0]
  v_pk_mul_f32 v[26:27], v[26:27], v[96:97] op_sel_hi:[1,0]
  s_waitcnt lgkmcnt(2)
  v_pk_fma_f32 v[24:25], v[28:29], v[98:99], v[24:25] op_sel_hi:[1,0,1]
  v_pk_fma_f32 v[26:27], v[30:31], v[98:99], v[26:27] op_sel_hi:[1,0,1]
  s_waitcnt lgkmcnt(1)
  v_pk_fma_f32 v[24:25], v[32:33], v[100:101], v[24:25] op_sel_hi:[1,0,1]
  v_pk_fma_f32 v[26:27], v[34:35], v[100:101], v[26:27] op_sel_hi:[1,0,1]
  s_waitcnt lgkmcnt(0)
  v_pk_fma_f32 v[24:25], v[36:37], v[102:103], v[24:25] op_sel_hi:[1,0,1]
  v_pk_fma_f32 v[26:27], v[38:39], v[102:103], v[26:27] op_sel_hi:[1,0,1]
  v_cvt_pk_bf16_f32 v16, v24, v25
  v_cvt_pk_bf16_f32 v17, v26, v27
  s_cbranch_scc0 L_oremote
  global_store_dwordx4 v116, v[16:19], s[26:27]
L_opub:
  s_mov_b32 exec_hi, -1
  global_load_dwordx4 v[40:43], v117, s[26:27] sc1
  global_load_dwordx4 v[44:47], v118, s[26:27] sc1
  s_waitcnt vmcnt(7)
L_gspin:
  v_xor_b32 v22, s32, v108
  v_bitop3_b32 v22, v22, v109, s33 bitop3:0xf6
  v_bitop3_b32 v22, v22, v110, s34 bitop3:0xf6
  v_bitop3_b32 v22, v22, v111, s35 bitop3:0xf6
  v_and_b32 v22, 0xff, v22
  v_cmp_ne_u32 vcc, 0, v22
  v_and_b32 v108, v14, v108
  v_and_b32 v109, v14, v109
  v_and_b32 v110, v14, v110
  v_and_b32 v111, v14, v111
  s_cbranch_vccz L_gok
  s_mov_b64 exec, vcc
  global_load_dwordx4 v[108:111], v123, s[26:27] sc1
  s_sub_u32 s40, s40, 1
  s_cbranch_scc1 L_end
  s_waitcnt vmcnt(0)
  s_branch L_gspin
L_gok:
  s_mov_b64 exec, -1
  v_permlane16_swap_b32 v108, v109
  v_permlane16_swap_b32 v110, v111
  v_add_f32 v30, v108, v109
  v_add_f32 v32, v110, v111
  v_mov_b32 v36, 0xc0135761
  s_mov_b32 s38, 0xbdd2d3e8
  v_add_f32_dpp v30, v30, v30 row_ror:8 row_mask:0xf bank_mask:0xf
  v_add_f32_dpp v32, v32, v32 row_ror:8 row_mask:0xf bank_mask:0xf
  s_nop 1
  v_permlane32_swap_b32 v30, v32
  v_cvt_pk_bf16_f32 v30, 0, v30
  v_cvt_pk_bf16_f32 v32, 0, v32
  v_mul_f32 v34, v30, v30
  v_fma_f32 v34, v34, s38, v36
  v_mul_f32 v34, v34, v30
  v_exp_f32 v34, v34
  s_nop 0
  v_add_f32 v34, 1.0, v34
  v_rcp_f32 v34, v34
  s_nop 0
  v_mul_f32 v34, v34, v30
  v_cvt_pk_bf16_f32 v34, 0, v34
  v_mul_f32 v34, v34, v32
  s_cmp_eq_u32 s46, 7
  s_cselect_b32 s38, 0, -1
  v_cvt_pk_bf16_f32 v34, v34, v34
  v_and_b32 v34, s38, v34
  s_nop 1
  v_and_b32_dpp v56, v34, v8 quad_perm:[0,0,0,0] row_mask:0xf bank_mask:0xf
  v_and_b32_dpp v57, v34, v9 quad_perm:[0,0,0,0] row_mask:0xf bank_mask:0xf
  v_and_b32_dpp v58, v34, v10 quad_perm:[0,0,0,0] row_mask:0xf bank_mask:0xf
  v_and_b32_dpp v59, v34, v11 quad_perm:[0,0,0,0] row_mask:0xf bank_mask:0xf
  v_and_b32_dpp v60, v34, v8 quad_perm:[1,1,1,1] row_mask:0xf bank_mask:0xf
  v_and_b32_dpp v61, v34, v9 quad_perm:[1,1,1,1] row_mask:0xf bank_mask:0xf
  v_and_b32_dpp v62, v34, v10 quad_perm:[1,1,1,1] row_mask:0xf bank_mask:0xf
  v_and_b32_dpp v63, v34, v11 quad_perm:[1,1,1,1] row_mask:0xf bank_mask:0xf
  v_mfma_f32_16x16x32_bf16 v[104:107], v[56:59], v[72:75], 0
  s_nop 0
  v_mfma_f32_16x16x32_bf16 v[104:107], v[60:63], v[76:79], v[104:107]
  s_waitcnt vmcnt(0)
L_ospin:
  v_xor_b32 v22, s30, v43
  v_bitop3_b32 v22, v22, v47, s30 bitop3:0xf6
  v_cmp_ne_u32 vcc, 0, v22
  s_cbranch_vccz L_ook
  s_mov_b64 exec, vcc
  global_load_dwordx4 v[40:43], v117, s[26:27] sc1
  global_load_dwordx4 v[44:47], v118, s[26:27] sc1
  s_sub_u32 s40, s40, 1
  s_cbranch_scc1 L_end
  s_waitcnt vmcnt(0)
  s_branch L_ospin
L_ook:
  s_mov_b64 exec, -1
  v_max_f32 v36, v42, v46
  v_lshlrev_b32 v24, 16, v40
  v_and_b32 v25, 0xffff0000, v40
  v_max_f32_dpp v36, v36, v36 row_ror:4 row_mask:0xf bank_mask:0xf
  v_lshlrev_b32 v26, 16, v41
  v_and_b32 v27, 0xffff0000, v41
  v_max_f32_dpp v36, v36, v36 row_ror:8 row_mask:0xf bank_mask:0xf
  v_mov_b32 v37, v36
  v_lshlrev_b32 v32, 16, v44
  v_and_b32 v33, 0xffff0000, v44
  v_permlane16_swap_b32 v36, v37
  v_max_f32 v36, v36, v37
  v_mov_b32 v37, v36
  v_lshlrev_b32 v34, 16, v45
  v_and_b32 v35, 0xffff0000, v45
  v_permlane32_swap_b32 v36, v37
  v_max_f32 v36, v36, v37
  v_sub_f32 v28, v42, v36
  v_sub_f32 v30, v46, v36
  v_exp_f32 v28, v28
  v_exp_f32 v30, v30
  v_pk_mul_f32 v[24:25], v[24:25], v[28:29] op_sel_hi:[1,0]
  v_pk_mul_f32 v[26:27], v[26:27], v[28:29] op_sel_hi:[1,0]
  v_add_f32 v36, v28, v30
  v_pk_fma_f32 v[32:33], v[32:33], v[30:31], v[24:25] op_sel_hi:[1,0,1]
  v_pk_fma_f32 v[34:35], v[34:35], v[30:31], v[26:27] op_sel_hi:[1,0,1]
  v_mov_b32 v37, v36
  s_nop 0
  v_permlane32_swap_b32 v32, v34
  v_permlane32_swap_b32 v33, v35
  v_permlane32_swap_b32 v36, v37
  v_pk_add_f32 v[32:33], v[32:33], v[34:35]
  v_add_f32 v36, v36, v37
  v_mov_b32 v37, v36
  v_permlane16_swap_b32 v32, v33
  s_nop 0
  v_permlane16_swap_b32 v36, v37
  v_add_f32 v32, v32, v33
  v_add_f32 v36, v36, v37
  s_nop 1
  v_add_f32_dpp v36, v36, v36 row_ror:4 row_mask:0xf bank_mask:0xf
  v_add_f32_dpp v32, v32, v32 row_ror:4 row_mask:0xf bank_mask:0xf
  s_nop 0
  v_add_f32_dpp v36, v36, v36 row_ror:8 row_mask:0xf bank_mask:0xf
  v_add_f32_dpp v32, v32, v32 row_ror:8 row_mask:0xf bank_mask:0xf
  v_rcp_f32 v36, v36
  s_nop 0
  v_mul_f32 v32, v32, v36
  v_cvt_pk_bf16_f32 v32, v32, v32
  s_nop 1
  v_and_b32_dpp v56, v32, v8 quad_perm:[0,0,0,0] row_mask:0xf bank_mask:0xf
  v_and_b32_dpp v57, v32, v9 quad_perm:[0,0,0,0] row_mask:0xf bank_mask:0xf
  v_and_b32_dpp v58, v32, v10 quad_perm:[0,0,0,0] row_mask:0xf bank_mask:0xf
  v_and_b32_dpp v59, v32, v11 quad_perm:[0,0,0,0] row_mask:0xf bank_mask:0xf
  v_and_b32_dpp v60, v32, v8 quad_perm:[1,1,1,1] row_mask:0xf bank_mask:0xf
  v_and_b32_dpp v61, v32, v9 quad_perm:[1,1,1,1] row_mask:0xf bank_mask:0xf
  v_and_b32_dpp v62, v32, v10 quad_perm:[1,1,1,1] row_mask:0xf bank_mask:0xf
  v_and_b32_dpp v63, v32, v11 quad_perm:[1,1,1,1] row_mask:0xf bank_mask:0xf
  v_mfma_f32_16x16x32_bf16 v[104:107], v[56:59], v[80:83], v[104:107]
  v_and_b32_dpp v64, v32, v8 quad_perm:[2,2,2,2] row_mask:0xf bank_mask:0xf
  v_and_b32_dpp v65, v32, v9 quad_perm:[2,2,2,2] row_mask:0xf bank_mask:0xf
  v_and_b32_dpp v66, v32, v10 quad_perm:[2,2,2,2] row_mask:0xf bank_mask:0xf
  v_and_b32_dpp v67, v32, v11 quad_perm:[2,2,2,2] row_mask:0xf bank_mask:0xf
  v_mfma_f32_16x16x32_bf16 v[104:107], v[60:63], v[84:87], v[104:107]
  v_and_b32_dpp v68, v32, v8 quad_perm:[3,3,3,3] row_mask:0xf bank_mask:0xf
  v_and_b32_dpp v69, v32, v9 quad_perm:[3,3,3,3] row_mask:0xf bank_mask:0xf
  v_and_b32_dpp v70, v32, v10 quad_perm:[3,3,3,3] row_mask:0xf bank_mask:0xf
  v_and_b32_dpp v71, v32, v11 quad_perm:[3,3,3,3] row_mask:0xf bank_mask:0xf
  v_mfma_f32_16x16x32_bf16 v[104:107], v[64:67], v[88:91], v[104:107]
  s_nop 0
  v_mfma_f32_16x16x32_bf16 v[104:107], v[68:71], v[92:95], v[104:107]
  s_cmp_lg_u32 s3, 0
  s_nop 6
  ds_write_b128 v113, v[104:107] offset:40960
  s_waitcnt lgkmcnt(0)
  s_barrier
  s_cbranch_scc1 L_notpub
  ds_read_b128 v[24:27], v122 offset:40960
  ds_read_b128 v[28:31], v122 offset:41984
  ds_read_b128 v[32:35], v122 offset:43008
  ds_read_b128 v[36:39], v122 offset:44032
  s_mov_b32 exec_hi, 0
  s_waitcnt lgkmcnt(2)
  v_pk_add_f32 v[24:25], v[24:25], v[28:29]
  v_pk_add_f32 v[26:27], v[26:27], v[30:31]
  s_waitcnt lgkmcnt(0)
  v_pk_add_f32 v[32:33], v[32:33], v[36:37]
  v_pk_add_f32 v[34:35], v[34:35], v[38:39]
  v_pk_add_f32 v[24:25], v[24:25], v[32:33]
  v_pk_add_f32 v[26:27], v[26:27], v[34:35]
  v_and_or_b32 v24, v24, v14, s32
  v_and_or_b32 v25, v25, v14, s33
  v_and_or_b32 v26, v26, v14, s34
  v_and_or_b32 v27, v27, v14, s35
  global_store_dwordx4 v119, v[24:27], s[26:27] sc1
  s_endpgm
L_notpub:
  s_cmp_lg_u32 s3, 2
  s_cbranch_scc1 L_fin
  s_cmp_ge_u32 s2, 128
  s_cbranch_scc1 L_fin
  global_load_dwordx4 v[24:27], v120, s[26:27] sc1
  v_lshlrev_b32 v28, 16, v125
  v_and_b32 v29, 0xffff0000, v125
  s_waitcnt vmcnt(0)
L_fspin:
  v_xor_b32 v22, s32, v24
  v_bitop3_b32 v22, v22, v25, s33 bitop3:0xf6
  v_bitop3_b32 v22, v22, v26, s34 bitop3:0xf6
  v_bitop3_b32 v22, v22, v27, s35 bitop3:0xf6
  v_and_b32 v22, 0xff, v22
  v_cmp_ne_u32 vcc, 0, v22
  v_and_b32 v24, v14, v24
  v_and_b32 v25, v14, v25
  v_and_b32 v26, v14, v26
  v_and_b32 v27, v14, v27
  s_cbranch_vccz L_fok
  s_mov_b64 exec, vcc
  global_load_dwordx4 v[24:27], v120, s[26:27] sc1
  s_sub_u32 s40, s40, 1
  s_cbranch_scc1 L_end
  s_waitcnt vmcnt(0)
  s_branch L_fspin
L_fok:
  s_mov_b64 exec, -1
  v_permlane32_swap_b32 v24, v26
  v_permlane32_swap_b32 v25, v27
  v_pk_add_f32 v[24:25], v[24:25], v[26:27]
  s_nop 1
  v_add_f32_dpp v24, v24, v24 row_ror:8 row_mask:0xf bank_mask:0xf
  v_add_f32_dpp v25, v25, v25 row_ror:8 row_mask:0xf bank_mask:0xf
  s_nop 0
  v_add_f32_dpp v24, v24, v24 row_ror:4 row_mask:0xf bank_mask:0xf
  v_add_f32_dpp v25, v25, v25 row_ror:4 row_mask:0xf bank_mask:0xf
  s_nop 0
  v_add_f32_dpp v24, v24, v24 row_ror:2 row_mask:0xf bank_mask:0xf
  v_add_f32_dpp v25, v25, v25 row_ror:2 row_mask:0xf bank_mask:0xf
  s_nop 0
  v_add_f32_dpp v24, v24, v24 row_ror:1 row_mask:0xf bank_mask:0xf
  v_add_f32_dpp v25, v25, v25 row_ror:1 row_mask:0xf bank_mask:0xf
  s_nop 0
  v_add_f32_dpp v24, v24, v24 row_bcast:15 row_mask:0xa bank_mask:0xf
  v_add_f32_dpp v25, v25, v25 row_bcast:15 row_mask:0xa bank_mask:0xf
  s_mov_b32 exec_lo, 0x80000000
  s_mov_b32 exec_hi, 0x80000000
  v_pk_add_f32 v[24:25], v[24:25], v[28:29]
  v_cvt_pk_bf16_f32 v24, v24, v25
  global_store_dword v121, v24, s[22:23]
  s_cmp_lg_u32 s2, 0
  s_cbranch_scc1 L_fin2
  s_mov_b32 exec_lo, 0
  v_mov_b32 v26, s30
  v_mov_b32 v27, 0
  global_store_dword v27, v26, s[26:27]
L_fin2:
  s_endpgm
L_oremote:
  global_store_dwordx4 v116, v[16:19], s[26:27] sc1
  s_branch L_opub
L_attn2:
  v_bfe_u32 v3, v0, 4, 2
  v_bfe_u32 v22, v0, 2, 2
  v_and_b32 v24, 3, v0
  s_add_u32 s52, s53, 6144
  v_xor_b32 v23, v3, v24
  v_lshlrev_b32 v23, 4, v23
  v_lshl_add_u32 v23, v24, 8, v23
  v_mul_u32_u24 v25, 1088, v22
  v_add3_u32 v7, v25, v23, s52
  v_lshrrev_b32 v23, 5, v1
  v_xor_b32 v23, v23, v22
  v_lshlrev_b32 v23, 6, v23
  v_lshl_add_u32 v23, v22, 8, v23
  v_and_b32 v25, 16, v0
  v_lshl_add_u32 v23, v25, 1, v23
  v_lshl_add_u32 v23, v24, 3, v23
  v_xor_b32 v25, 0x80, v23
  v_add_u32 v8, s52, v23
  v_lshlrev_b32 v23, 4, v3
  v_lshl_add_u32 v9, v24, 8, v23
  s_lshl_b32 s38, s61, 3
  v_lshl_add_u32 v10, v24, 5, s38
  v_mul_u32_u24 v26, 544, v24
  v_lshrrev_b32 v23, 2, v1
  v_lshl_add_u32 v26, v23, 4, v26
  v_add_u32 v11, s52, v26
  v_mov_b32 v14, 0x3db504f3
  s_mov_b32 s50, 0x3fb8aa3b
  s_barrier
  s_barrier
  s_add_u32 m0, s53, 8320
  v_add_u32 v5, s54, v5
  v_and_b32 v5, s55, v5
  global_load_lds_dwordx4 v5, s[6:7] nt
  s_add_u32 m0, s53, 9408
  v_add_u32 v5, s54, v5
  v_and_b32 v5, s55, v5
  global_load_lds_dwordx4 v5, s[6:7] nt
  s_add_u32 m0, s53, 10496
  v_add_u32 v5, s54, v5
  v_and_b32 v5, s55, v5
  global_load_lds_dwordx4 v5, s[6:7] nt
  s_add_u32 m0, s53, 11584
  v_add_u32 v5, s54, v5
  v_and_b32 v5, s55, v5
  global_load_lds_dwordx4 v5, s[6:7] nt
  s_add_u32 m0, s53, 12672
  v_add_u32 v5, s54, v5
  v_and_b32 v5, s55, v5
  global_load_lds_dwordx4 v5, s[6:7] nt
  s_waitcnt vmcnt(6)
  v_add_u32 v13, s52, v25
  s_add_u32 m0, s53, 13760
  v_add_u32 v5, s54, v5
  v_and_b32 v5, s55, v5
  global_load_lds_dwordx4 v5, s[6:7] nt
  s_waitcnt vmcnt(6)
  s_add_u32 m0, s53, 40960
  s_nop 0
  global_load_lds_dwordx4 v6, s[8:9] nt
  s_waitcnt vmcnt(6)
  s_add_u32 m0, s53, 42048
  v_add_u32 v6, s54, v6
  v_and_b32 v6, s55, v6
  global_load_lds_dwordx4 v6, s[8:9] nt
  s_waitcnt vmcnt(6)
  s_add_u32 m0, s53, 43136
  v_add_u32 v6, s54, v6
  v_and_b32 v6, s55, v6
  global_load_lds_dwordx4 v6, s[8:9] nt
  ds_read_b128 v[40:43], v7 offset:0
  ds_read_b128 v[44:47], v7 offset:64
  ds_read_b128 v[48:51], v7 offset:128
  ds_read_b128 v[52:55], v7 offset:192
  s_waitcnt vmcnt(6)
  s_add_u32 m0, s53, 44224
  v_add_u32 v6, s54, v6
  v_and_b32 v6, s55, v6
  global_load_lds_dwordx4 v6, s[8:9] nt
  s_waitcnt vmcnt(6)
  s_add_u32 m0, s53, 45312
  v_add_u32 v6, s54, v6
  v_and_b32 v6, s55, v6
  global_load_lds_dwordx4 v6, s[8:9] nt
  s_waitcnt vmcnt(6)
  s_add_u32 m0, s53, 46400
  v_add_u32 v6, s54, v6
  v_and_b32 v6, s55, v6
  global_load_lds_dwordx4 v6, s[8:9] nt
  s_waitcnt vmcnt(6)
  s_add_u32 m0, s53, 47488
  v_add_u32 v6, s54, v6
  v_and_b32 v6, s55, v6
  global_load_lds_dwordx4 v6, s[8:9] nt
  s_add_u32 m0, s53, 48576
  v_add_u32 v6, s54, v6
  v_and_b32 v6, s55, v6
  global_load_lds_dwordx4 v6, s[8:9] nt
  ds_read_b128 v[56:59], v7 offset:4352
  ds_read_b128 v[60:63], v7 offset:4416
  ds_read_b128 v[64:67], v7 offset:4480
  ds_read_b128 v[68:71], v7 offset:4544
  s_barrier
  ds_read_b128 v[104:107], v9 offset:0
  ds_read_b128 v[108:111], v9 offset:64
  ds_read_b128 v[112:115], v9 offset:128
  ds_read_b128 v[116:119], v9 offset:192
  s_waitcnt lgkmcnt(3)
  v_mfma_f32_16x16x32_bf16 v[120:123], v[40:43], v[104:107], 0
  v_mfma_f32_16x16x32_bf16 v[124:127], v[56:59], v[104:107], 0
  s_waitcnt lgkmcnt(2)
  v_mfma_f32_16x16x32_bf16 v[120:123], v[44:47], v[108:111], v[120:123]
  v_mfma_f32_16x16x32_bf16 v[124:127], v[60:63], v[108:111], v[124:127]
  s_waitcnt lgkmcnt(1)
  v_mfma_f32_16x16x32_bf16 v[120:123], v[48:51], v[112:115], v[120:123]
  v_mfma_f32_16x16x32_bf16 v[124:127], v[64:67], v[112:115], v[124:127]
  s_waitcnt lgkmcnt(0)
  v_mfma_f32_16x16x32_bf16 v[120:123], v[52:55], v[116:119], v[120:123]
  v_mfma_f32_16x16x32_bf16 v[124:127], v[68:71], v[116:119], v[124:127]
  s_nop 6
  v_cvt_pk_bf16_f32 v120, 0, v120
  v_cvt_pk_bf16_f32 v121, 0, v121
  v_cvt_pk_bf16_f32 v122, 0, v122
  v_cvt_pk_bf16_f32 v123, 0, v123
  v_cvt_pk_bf16_f32 v124, 0, v124
  v_cvt_pk_bf16_f32 v125, 0, v125
  v_cvt_pk_bf16_f32 v126, 0, v126
  v_cvt_pk_bf16_f32 v127, 0, v127
  v_pk_mul_f32 v[120:121], v[120:121], v[14:15] op_sel_hi:[1,0]
  v_pk_mul_f32 v[122:123], v[122:123], v[14:15] op_sel_hi:[1,0]
  v_pk_mul_f32 v[124:125], v[124:125], v[14:15] op_sel_hi:[1,0]
  v_pk_mul_f32 v[126:127], v[126:127], v[14:15] op_sel_hi:[1,0]
  v_cvt_pk_bf16_f32 v120, 0, v120
  v_cvt_pk_bf16_f32 v121, 0, v121
  v_cvt_pk_bf16_f32 v122, 0, v122
  v_cvt_pk_bf16_f32 v123, 0, v123
  v_cvt_pk_bf16_f32 v124, 0, v124
  v_cvt_pk_bf16_f32 v125, 0, v125
  v_cvt_pk_bf16_f32 v126, 0, v126
  v_cvt_pk_bf16_f32 v127, 0, v127
  v_max3_f32 v22, v120, v121, v122
  v_max3_f32 v23, v123, v124, v125
  v_max3_f32 v22, v126, v127, v22
  v_max_f32 v22, v22, v23
  v_mov_b32 v23, v22
  s_nop 1
  v_permlane16_swap_b32 v22, v23
  v_max_f32 v22, v22, v23
  v_mov_b32 v23, v22
  s_nop 1
  v_permlane32_swap_b32 v22, v23
  v_max_f32 v22, v22, v23
  v_mul_f32 v20, s50, v22
  v_fma_f32 v120, v120, s50, -v20
  v_fma_f32 v121, v121, s50, -v20
  v_fma_f32 v122, v122, s50, -v20
  v_fma_f32 v123, v123, s50, -v20
  v_fma_f32 v124, v124, s50, -v20
  v_fma_f32 v125, v125, s50, -v20
  v_fma_f32 v126, v126, s50, -v20
  v_fma_f32 v127, v127, s50, -v20
  v_exp_f32 v120, v120
  v_exp_f32 v121, v121
  v_exp_f32 v122, v122
  v_exp_f32 v123, v123
  v_exp_f32 v124, v124
  v_exp_f32 v125, v125
  v_exp_f32 v126, v126
  v_exp_f32 v127, v127
  v_pk_add_f32 v[32:33], v[120:121], v[122:123]
  v_pk_add_f32 v[34:35], v[124:125], v[126:127]
  v_cvt_pk_bf16_f32 v16, v120, v121
  v_pk_add_f32 v[32:33], v[32:33], v[34:35]
  v_cvt_pk_bf16_f32 v17, v122, v123
  v_add_f32 v32, v32, v33
  v_mov_b32 v33, v32
  v_cvt_pk_bf16_f32 v18, v124, v125
  v_cvt_pk_bf16_f32 v19, v126, v127
  v_permlane16_swap_b32 v32, v33
  v_add_f32 v32, v32, v33
  v_mov_b32 v33, v32
  s_nop 1
  v_permlane32_swap_b32 v32, v33
  v_add_f32 v21, v32, v33
  ds_write_b64 v10, v[20:21] offset:1024
  s_waitcnt lgkmcnt(0)
  s_barrier
  s_waitcnt vmcnt(7)
  ds_read_b64_tr_b16 v[72:73], v8 offset:34816
  ds_read_b64_tr_b16 v[74:75], v13 offset:34816
  s_waitcnt vmcnt(6)
  ds_read_b64_tr_b16 v[76:77], v8 offset:35904
  ds_read_b64_tr_b16 v[78:79], v13 offset:35904
  s_waitcnt vmcnt(5)
  ds_read_b64_tr_b16 v[80:81], v8 offset:36992
  ds_read_b64_tr_b16 v[82:83], v13 offset:36992
  s_waitcnt lgkmcnt(4)
  v_mfma_f32_4x4x4_16b_bf16 v[24:27], v[72:73], v[16:17], 0 blgp:4
  v_mfma_f32_4x4x4_16b_bf16 v[28:31], v[74:75], v[16:17], 0 blgp:4
  s_waitcnt vmcnt(4)
  ds_read_b64_tr_b16 v[84:85], v8 offset:38080
  ds_read_b64_tr_b16 v[86:87], v13 offset:38080
  s_waitcnt lgkmcnt(4)
  v_mfma_f32_4x4x4_16b_bf16 v[24:27], v[76:77], v[16:17], v[24:27] blgp:5
  v_mfma_f32_4x4x4_16b_bf16 v[28:31], v[78:79], v[16:17], v[28:31] blgp:5
  s_waitcnt vmcnt(3)
  ds_read_b64_tr_b16 v[88:89], v8 offset:39168
  ds_read_b64_tr_b16 v[90:91], v13 offset:39168
  s_waitcnt lgkmcnt(4)
  v_mfma_f32_4x4x4_16b_bf16 v[24:27], v[80:81], v[16:17], v[24:27] blgp:6
  v_mfma_f32_4x4x4_16b_bf16 v[28:31], v[82:83], v[16:17], v[28:31] blgp:6
  s_waitcnt vmcnt(2)
  ds_read_b64_tr_b16 v[92:93], v8 offset:40256
  ds_read_b64_tr_b16 v[94:95], v13 offset:40256
  s_waitcnt lgkmcnt(4)
  v_mfma_f32_4x4x4_16b_bf16 v[24:27], v[84:85], v[16:17], v[24:27] blgp:7
  v_mfma_f32_4x4x4_16b_bf16 v[28:31], v[86:87], v[16:17], v[28:31] blgp:7
  s_waitcnt vmcnt(1)
  ds_read_b64_tr_b16 v[96:97], v8 offset:41344
  ds_read_b64_tr_b16 v[98:99], v13 offset:41344
  s_waitcnt lgkmcnt(4)
  v_mfma_f32_4x4x4_16b_bf16 v[24:27], v[88:89], v[18:19], v[24:27] blgp:4
  v_mfma_f32_4x4x4_16b_bf16 v[28:31], v[90:91], v[18:19], v[28:31] blgp:4
  s_waitcnt vmcnt(0)
  ds_read_b64_tr_b16 v[100:101], v8 offset:42432
  ds_read_b64_tr_b16 v[102:103], v13 offset:42432
  s_waitcnt lgkmcnt(4)
  v_mfma_f32_4x4x4_16b_bf16 v[24:27], v[92:93], v[18:19], v[24:27] blgp:5
  v_mfma_f32_4x4x4_16b_bf16 v[28:31], v[94:95], v[18:19], v[28:31] blgp:5
  s_waitcnt lgkmcnt(2)
  v_mfma_f32_4x4x4_16b_bf16 v[24:27], v[96:97], v[18:19], v[24:27] blgp:6
  v_mfma_f32_4x4x4_16b_bf16 v[28:31], v[98:99], v[18:19], v[28:31] blgp:6
  s_waitcnt lgkmcnt(0)
  v_mfma_f32_4x4x4_16b_bf16 v[24:27], v[100:101], v[18:19], v[24:27] blgp:7
  v_mfma_f32_4x4x4_16b_bf16 v[28:31], v[102:103], v[18:19], v[28:31] blgp:7
  s_nop 3
  ds_write_b128 v11, v[24:27]
  ds_write_b128 v11, v[28:31] offset:256
  s_waitcnt lgkmcnt(0)
  s_barrier
L_fin:
L_end:
  s_endpgm
L_code_end:
.section .rodata,"a"
.p2align 6
.amdhsa_kernel parallel_sum__sliding_block_cached__geglu_ffn__decode_kernel
  .amdhsa_next_free_vgpr 128
  .amdhsa_next_free_sgpr 64
  .amdhsa_accum_offset 128
  .amdhsa_group_segment_fixed_size 0
  .amdhsa_kernarg_size 96
  .amdhsa_user_sgpr_count 2
  .amdhsa_user_sgpr_kernarg_segment_ptr 1
  .amdhsa_system_sgpr_workgroup_id_x 1
.end_amdhsa_kernel
```
